```python
import torch

def _softmax(x, axis=-1):
    return torch.softmax(x, dim=axis)
def _gelu(x):
    return torch.nn.functional.gelu(x, approximate="tanh")
def _silu(x):
    return torch.nn.functional.silu(x)
def _sigmoid(x):
    return torch.sigmoid(x)
def _layernorm(x, axis=-1, eps=1e-5):
    m = x.mean(dim=axis, keepdim=True)
    v = x.var(dim=axis, keepdim=True, unbiased=False)
    return (x - m) / torch.sqrt(v + eps)
def _scatter_add(tgt, idx, src, axis=0):
    return tgt.clone().index_add_(axis, idx, src)
def _segment_sum(src, seg, n):
    out = torch.zeros((n,) + src.shape[1:], dtype=src.dtype)
    return out.index_add_(0, seg, src)
def _pad(x, pw):
    flat = tuple(v for pair in reversed(pw) for v in pair)
    return torch.nn.functional.pad(x, flat)

kernel_name = 'standalone__weight_only_int_omniquant__prompt'

def setup_inputs():

    _w = (lambda a: (lambda t: t.to(torch.bfloat16) if t.is_floating_point() else t)(torch.as_tensor(a)))
    B, S, D, F = 1, 2048, 1024, 3584
    bits = 4
    G = -1 if -1 > 0 else D
    D = (D // G) * G
    ng = D // G
    qmax = (1 << bits) - 1
    qw = torch.randint(0, qmax + 1, (D, F)).to(torch.int32)
    scales = (torch.abs((lambda *s: torch.randn(*s, dtype=torch.bfloat16) * 0.05)(ng, F)) * 0.05 + 0.01).to(float)
    zeros = torch.randint(0, qmax + 1, (ng, F)).to(float)
    act_scale = (torch.abs((lambda *s: torch.randn(*s, dtype=torch.bfloat16) * 0.05)(D)) * 0.5 + 0.5).to(float)
    return {
        "x": _w((lambda *s: torch.randn(*s, dtype=torch.bfloat16) * 0.05)(B, S, D)),
        "qw": _w(qw),
        "scales": _w(scales),
        "zeros": _w(zeros),
        "act_scale": _w(act_scale),
    }

def reference(x, qw, scales, zeros, act_scale):
    B, S, D = x.shape
    ng, F = scales.shape
    G = D // ng
    s = (lambda x, n, axis: torch.repeat_interleave(x, n, dim=axis))(scales, G, axis=0)
    z = (lambda x, n, axis: torch.repeat_interleave(x, n, dim=axis))(zeros, G, axis=0)
    w = ((lambda x, dt: x.to(dt))(qw, x.dtype) - z) * s
    xs = x * (lambda x, dt: x.to(dt))(act_scale, x.dtype)
    return torch.einsum("bsd,df->bsf", xs, w)
```

```asm
; @launch grid=(224,1,1) block=(512,1,1) lds=135168
.amdgcn_target "amdgcn-amd-amdhsa--gfx950"
.text
.globl standalone__weight_only_int_omniquant__prompt_kernel
.p2align 8
.type standalone__weight_only_int_omniquant__prompt_kernel,@function
standalone__weight_only_int_omniquant__prompt_kernel:
    s_cmp_ge_u32 s2, 224
    s_cbranch_scc1 L_exit
    s_load_dwordx4 s[4:7], s[0:1], 0
    s_load_dwordx4 s[12:15], s[0:1], 32
    s_load_dwordx4 s[8:11], s[0:1], 16
    v_lshrrev_b32 v1, 6, v0
    v_and_b32 v2, 63, v0
    v_readfirstlane_b32 s28, v1
    s_and_b32 s45, s2, 7
    s_lshr_b32 s47, s2, 3
    s_lshr_b32 s30, s47, 2
    s_lshr_b32 s31, s45, 1
    s_mul_i32 s31, s31, 7
    s_add_u32 s31, s30, s31
    s_and_b32 s29, s47, 3
    v_and_b32 v3, 31, v0
    v_bfe_u32 v1, v0, 5, 1
    s_cmp_ge_u32 s28, 4
    s_cbranch_scc0 L_consumer
    s_add_u32 s46, s29, s30
    s_and_b32 s46, s46, 3
    s_and_b32 s42, s30, 4
    s_or_b32 s46, s46, s42
    s_lshl_b32 s42, s46, 2
    s_lshr_b32 s37, 0x100210, s42
    s_and_b32 s37, s37, 15
    s_lshl_b32 s33, s31, 9
    s_lshl_b32 s35, s31, 8
    s_sub_u32 s31, s28, 4
    s_lshl_b32 s36, s31, 4
    v_lshl_add_u32 v10, v1, 3, s36
    v_mul_u32_u24 v10, 14336, v10
    v_lshl_add_u32 v200, v3, 4, v10
    v_add_u32 v201, 14336, v200
    v_add_u32 v202, 28672, v200
    v_add_u32 v203, 43008, v200
    v_add_u32 v204, 57344, v200
    v_add_u32 v205, 71680, v200
    v_add_u32 v206, 86016, v200
    v_add_u32 v207, 100352, v200
    s_mul_i32 s36, s37, 917504
    s_waitcnt lgkmcnt(0)
    s_add_u32 s20, s6, s33
    s_addc_u32 s21, s7, 0
    s_sub_u32 s22, 14680064, s33
    s_mov_b32 s23, 0x20000
    buffer_load_dwordx4 v[64:67], v200, s[20:23], s36 offen
    buffer_load_dwordx4 v[68:71], v201, s[20:23], s36 offen
    buffer_load_dwordx4 v[72:75], v202, s[20:23], s36 offen
    buffer_load_dwordx4 v[76:79], v203, s[20:23], s36 offen
    buffer_load_dwordx4 v[80:83], v204, s[20:23], s36 offen
    buffer_load_dwordx4 v[84:87], v205, s[20:23], s36 offen
    buffer_load_dwordx4 v[88:91], v206, s[20:23], s36 offen
    buffer_load_dwordx4 v[92:95], v207, s[20:23], s36 offen
    v_lshl_add_u32 v10, v3, 3, s35
    global_load_dwordx2 v[24:25], v10, s[8:9]
    global_load_dwordx2 v[26:27], v10, s[10:11]
    s_and_b32 s42, s2, 1
    s_lshl_b32 s42, s42, 2
    s_add_u32 s29, s29, s42
    s_lshl_b32 s32, s29, 19
    s_add_u32 s16, s4, s32
    s_addc_u32 s17, s5, 0
    s_sub_u32 s18, 4194304, s32
    s_mov_b32 s19, 0x20000
    v_lshrrev_b32 v10, 3, v2
    v_and_b32 v12, 7, v2
    v_lshrrev_b32 v13, 4, v2
    v_xor_b32 v12, v12, v13
    v_lshlrev_b32 v12, 4, v12
    v_lshl_add_u32 v208, v10, 11, v12
    v_xor_b32 v209, 64, v208
    v_add_u32 v215, 111616, v209
    v_add_u32 v214, 96256, v208
    v_add_u32 v213, 80896, v209
    v_add_u32 v212, 65536, v208
    v_add_u32 v211, 46080, v209
    v_add_u32 v210, 30720, v208
    v_add_u32 v209, 15360, v209
    s_lshl_b32 s39, s31, 13
    s_lshl_b32 s41, s31, 17
    s_add_u32 s38, s39, 98304
    s_mov_b32 s43, s39
    v_add_u32 v208, s41, v208
    v_add_u32 v209, s41, v209
    v_add_u32 v210, s41, v210
    v_add_u32 v211, s41, v211
    v_add_u32 v212, s41, v212
    v_add_u32 v213, s41, v213
    v_add_u32 v214, s41, v214
    v_add_u32 v215, s41, v215
    s_lshl_b32 s40, s37, 7
    s_mov_b32 m0, s43
    s_nop 0
    buffer_load_dwordx4 v208, s[16:19], s40 offen offset:0 lds
    buffer_load_dwordx4 v209, s[16:19], s40 offen offset:1024 lds
    buffer_load_dwordx4 v210, s[16:19], s40 offen offset:2048 lds
    buffer_load_dwordx4 v211, s[16:19], s40 offen offset:3072 lds
    s_add_u32 m0, s43, 4096
    s_nop 0
    buffer_load_dwordx4 v212, s[16:19], s40 offen offset:0 lds
    buffer_load_dwordx4 v213, s[16:19], s40 offen offset:1024 lds
    buffer_load_dwordx4 v214, s[16:19], s40 offen offset:2048 lds
    buffer_load_dwordx4 v215, s[16:19], s40 offen offset:3072 lds
    s_add_u32 s43, s43, 32768
    s_cmp_eq_u32 s43, s38
    s_cselect_b32 s43, s39, s43
    s_mov_b32 m0, s43
    s_mov_b32 s52, 0x68534210
    s_mov_b32 s53, 0xfedbca97
    s_cmp_eq_u32 s46, 1
    s_cselect_b32 s52, 0x96453201, s52
    s_cselect_b32 s53, 0xfecdba87, s53
    s_cmp_eq_u32 s46, 2
    s_cselect_b32 s52, 0x75643102, s52
    s_cselect_b32 s53, 0xfdecb98a, s53
    s_cmp_eq_u32 s46, 3
    s_cselect_b32 s52, 0x67542130, s52
    s_cselect_b32 s53, 0xefdca9b8, s53
    s_cmp_eq_u32 s46, 4
    s_cselect_b32 s52, 0x86532410, s52
    s_cselect_b32 s53, 0xfedbac97, s53
    s_cmp_eq_u32 s46, 5
    s_cselect_b32 s52, 0x76435201, s52
    s_cselect_b32 s53, 0xfecbda89, s53
    s_cmp_eq_u32 s46, 6
    s_cselect_b32 s52, 0x75463120, s52
    s_cselect_b32 s53, 0xfdceb9a8, s53
    s_cmp_eq_u32 s46, 7
    s_cselect_b32 s52, 0x65742310, s52
    s_cselect_b32 s53, 0xedfcab98, s53
    s_lshr_b64 s[52:53], s[52:53], 4
    s_lshl_b32 s42, s31, 12
    s_add_u32 s42, s42, 98304
    v_lshl_add_u32 v7, v2, 4, s42
    s_lshl_b32 s42, s31, 6
    s_add_u32 s42, s42, 131072
    v_lshl_add_u32 v9, v1, 5, s42
    s_mov_b32 s47, s40
    s_and_b32 s37, s52, 15
    s_lshr_b64 s[52:53], s[52:53], 4
    s_mul_i32 s36, s37, 917504
    s_lshl_b32 s40, s37, 7
    s_barrier
    v_lshl_add_u32 v12, s47, 1, v9
    ds_read_b128 v[48:51], v12
    ds_read_b128 v[52:55], v12 offset:16
    s_waitcnt vmcnt(8)
    v_lshlrev_b32 v16, 16, v24
    v_lshlrev_b32 v20, 16, v26
    v_and_b32 v17, 0xffff0000, v24
    v_and_b32 v21, 0xffff0000, v26
    v_lshlrev_b32 v18, 16, v25
    v_lshlrev_b32 v22, 16, v27
    v_and_b32 v19, 0xffff0000, v25
    v_and_b32 v23, 0xffff0000, v27
    v_mul_f32 v20, v20, v16
    v_mul_f32 v16, 0x71800000, v16
    v_mul_f32 v20, 0x27000000, v20
    v_mul_f32 v21, v21, v17
    v_mul_f32 v17, 0x71800000, v17
    v_mul_f32 v21, 0x27000000, v21
    v_mul_f32 v22, v22, v18
    v_mul_f32 v18, 0x71800000, v18
    v_mul_f32 v22, 0x27000000, v22
    v_mul_f32 v23, v23, v19
    v_mul_f32 v19, 0x71800000, v19
    v_mul_f32 v23, 0x27000000, v23
    s_setprio 2
    s_waitcnt vmcnt(10) lgkmcnt(0)
    v_lshl_add_u32 v12, s40, 1, v9
    ds_read_b128 v[56:59], v12
    ds_read_b128 v[60:63], v12 offset:16
    v_fma_f32 v64, v64, v16, -v20
    v_fma_f32 v68, v68, v16, -v20
    v_fma_f32 v72, v72, v16, -v20
    v_fma_f32 v76, v76, v16, -v20
    v_mul_f32 v64, v64, v48
    v_mul_f32 v68, v68, v49
    v_mul_f32 v72, v72, v50
    v_mul_f32 v76, v76, v51
    buffer_load_dwordx4 v[96:99], v200, s[20:23], s36 offen
    v_cvt_pk_bf16_f32 v32, v64, v68
    v_cvt_pk_bf16_f32 v33, v72, v76
    v_fma_f32 v80, v80, v16, -v20
    v_fma_f32 v84, v84, v16, -v20
    v_fma_f32 v88, v88, v16, -v20
    v_fma_f32 v92, v92, v16, -v20
    v_mul_f32 v80, v80, v52
    v_mul_f32 v84, v84, v53
    buffer_load_dwordx4 v[100:103], v201, s[20:23], s36 offen
    v_mul_f32 v88, v88, v54
    v_mul_f32 v92, v92, v55
    v_cvt_pk_bf16_f32 v34, v80, v84
    v_cvt_pk_bf16_f32 v35, v88, v92
    v_fma_f32 v65, v65, v17, -v21
    v_fma_f32 v69, v69, v17, -v21
    v_fma_f32 v73, v73, v17, -v21
    buffer_load_dwordx4 v[104:107], v202, s[20:23], s36 offen
    v_fma_f32 v77, v77, v17, -v21
    v_mul_f32 v65, v65, v48
    v_mul_f32 v69, v69, v49
    v_mul_f32 v73, v73, v50
    v_mul_f32 v77, v77, v51
    v_cvt_pk_bf16_f32 v36, v65, v69
    v_cvt_pk_bf16_f32 v37, v73, v77
    v_fma_f32 v81, v81, v17, -v21
    buffer_load_dwordx4 v[108:111], v203, s[20:23], s36 offen
    v_fma_f32 v85, v85, v17, -v21
    v_fma_f32 v89, v89, v17, -v21
    v_fma_f32 v93, v93, v17, -v21
    v_mul_f32 v81, v81, v52
    v_mul_f32 v85, v85, v53
    v_mul_f32 v89, v89, v54
    v_mul_f32 v93, v93, v55
    v_cvt_pk_bf16_f32 v38, v81, v85
    buffer_load_dwordx4 v[112:115], v204, s[20:23], s36 offen
    v_cvt_pk_bf16_f32 v39, v89, v93
    v_fma_f32 v66, v66, v18, -v22
    v_fma_f32 v70, v70, v18, -v22
    v_fma_f32 v74, v74, v18, -v22
    v_fma_f32 v78, v78, v18, -v22
    v_mul_f32 v66, v66, v48
    v_mul_f32 v70, v70, v49
    buffer_load_dwordx4 v[116:119], v205, s[20:23], s36 offen
    v_mul_f32 v74, v74, v50
    v_mul_f32 v78, v78, v51
    v_cvt_pk_bf16_f32 v40, v66, v70
    v_cvt_pk_bf16_f32 v41, v74, v78
    v_fma_f32 v82, v82, v18, -v22
    v_fma_f32 v86, v86, v18, -v22
    v_fma_f32 v90, v90, v18, -v22
    v_fma_f32 v94, v94, v18, -v22
    buffer_load_dwordx4 v[120:123], v206, s[20:23], s36 offen
    v_mul_f32 v82, v82, v52
    v_mul_f32 v86, v86, v53
    v_mul_f32 v90, v90, v54
    v_mul_f32 v94, v94, v55
    v_cvt_pk_bf16_f32 v42, v82, v86
    v_cvt_pk_bf16_f32 v43, v90, v94
    ds_write_b128 v7, v[32:35] offset:0
    v_fma_f32 v67, v67, v19, -v23
    buffer_load_dwordx4 v[124:127], v207, s[20:23], s36 offen
    v_fma_f32 v71, v71, v19, -v23
    v_fma_f32 v75, v75, v19, -v23
    v_fma_f32 v79, v79, v19, -v23
    v_mul_f32 v67, v67, v48
    v_mul_f32 v71, v71, v49
    ds_write_b128 v7, v[36:39] offset:1024
    v_mul_f32 v75, v75, v50
    buffer_load_dwordx4 v208, s[16:19], s40 offen offset:0 lds
    v_mul_f32 v79, v79, v51
    v_cvt_pk_bf16_f32 v44, v67, v71
    v_cvt_pk_bf16_f32 v45, v75, v79
    v_fma_f32 v83, v83, v19, -v23
    v_fma_f32 v87, v87, v19, -v23
    v_fma_f32 v91, v91, v19, -v23
    ds_write_b128 v7, v[40:43] offset:2048
    v_fma_f32 v95, v95, v19, -v23
    buffer_load_dwordx4 v209, s[16:19], s40 offen offset:1024 lds
    v_mul_f32 v83, v83, v52
    v_mul_f32 v87, v87, v53
    v_mul_f32 v91, v91, v54
    v_mul_f32 v95, v95, v55
    v_cvt_pk_bf16_f32 v46, v83, v87
    v_cvt_pk_bf16_f32 v47, v91, v95
    ds_write_b128 v7, v[44:47] offset:3072
    buffer_load_dwordx4 v210, s[16:19], s40 offen offset:2048 lds
    buffer_load_dwordx4 v211, s[16:19], s40 offen offset:3072 lds
    s_add_u32 m0, s43, 4096
    buffer_load_dwordx4 v212, s[16:19], s40 offen offset:0 lds
    buffer_load_dwordx4 v213, s[16:19], s40 offen offset:1024 lds
    buffer_load_dwordx4 v214, s[16:19], s40 offen offset:2048 lds
    buffer_load_dwordx4 v215, s[16:19], s40 offen offset:3072 lds
    s_add_u32 s43, s43, 32768
    s_cmp_eq_u32 s43, s38
    s_cselect_b32 s43, s39, s43
    s_mov_b32 m0, s43
    s_and_b32 s37, s52, 15
    s_lshr_b64 s[52:53], s[52:53], 4
    s_mul_i32 s36, s37, 917504
    s_lshl_b32 s40, s37, 7
    s_waitcnt vmcnt(16) lgkmcnt(0)
    s_barrier
    s_mov_b32 s44, 6
    .p2align 6
L_p_loop:
    buffer_load_dwordx4 v[64:67], v200, s[20:23], s36 offen
    buffer_load_dwordx4 v[68:71], v201, s[20:23], s36 offen
    s_waitcnt vmcnt(10) lgkmcnt(0)
    v_lshl_add_u32 v12, s40, 1, v9
    ds_read_b128 v[48:51], v12
    ds_read_b128 v[52:55], v12 offset:16
    v_fma_f32 v96, v96, v16, -v20
    v_fma_f32 v100, v100, v16, -v20
    v_fma_f32 v104, v104, v16, -v20
    v_fma_f32 v108, v108, v16, -v20
    v_mul_f32 v96, v96, v56
    v_mul_f32 v100, v100, v57
    v_mul_f32 v104, v104, v58
    v_mul_f32 v108, v108, v59
    v_cvt_pk_bf16_f32 v32, v96, v100
    v_cvt_pk_bf16_f32 v33, v104, v108
    buffer_load_dwordx4 v[72:75], v202, s[20:23], s36 offen
    v_fma_f32 v112, v112, v16, -v20
    v_fma_f32 v116, v116, v16, -v20
    v_fma_f32 v120, v120, v16, -v20
    v_fma_f32 v124, v124, v16, -v20
    v_mul_f32 v112, v112, v60
    v_mul_f32 v116, v116, v61
    v_mul_f32 v120, v120, v62
    v_mul_f32 v124, v124, v63
    v_cvt_pk_bf16_f32 v34, v112, v116
    buffer_load_dwordx4 v[76:79], v203, s[20:23], s36 offen
    v_cvt_pk_bf16_f32 v35, v120, v124
    v_fma_f32 v97, v97, v17, -v21
    v_fma_f32 v101, v101, v17, -v21
    v_fma_f32 v105, v105, v17, -v21
    v_fma_f32 v109, v109, v17, -v21
    v_mul_f32 v97, v97, v56
    v_mul_f32 v101, v101, v57
    v_mul_f32 v105, v105, v58
    v_mul_f32 v109, v109, v59
    buffer_load_dwordx4 v[80:83], v204, s[20:23], s36 offen
    v_cvt_pk_bf16_f32 v36, v97, v101
    v_cvt_pk_bf16_f32 v37, v105, v109
    v_fma_f32 v113, v113, v17, -v21
    v_fma_f32 v117, v117, v17, -v21
    v_fma_f32 v121, v121, v17, -v21
    v_fma_f32 v125, v125, v17, -v21
    v_mul_f32 v113, v113, v60
    v_mul_f32 v117, v117, v61
    v_mul_f32 v121, v121, v62
    v_mul_f32 v125, v125, v63
    buffer_load_dwordx4 v[84:87], v205, s[20:23], s36 offen
    v_cvt_pk_bf16_f32 v38, v113, v117
    v_cvt_pk_bf16_f32 v39, v121, v125
    v_fma_f32 v98, v98, v18, -v22
    v_fma_f32 v102, v102, v18, -v22
    v_fma_f32 v106, v106, v18, -v22
    v_fma_f32 v110, v110, v18, -v22
    v_mul_f32 v98, v98, v56
    v_mul_f32 v102, v102, v57
    v_mul_f32 v106, v106, v58
    buffer_load_dwordx4 v[88:91], v206, s[20:23], s36 offen
    v_mul_f32 v110, v110, v59
    v_cvt_pk_bf16_f32 v40, v98, v102
    v_cvt_pk_bf16_f32 v41, v106, v110
    v_fma_f32 v114, v114, v18, -v22
    v_fma_f32 v118, v118, v18, -v22
    v_fma_f32 v122, v122, v18, -v22
    v_fma_f32 v126, v126, v18, -v22
    v_mul_f32 v114, v114, v60
    v_mul_f32 v118, v118, v61
    buffer_load_dwordx4 v[92:95], v207, s[20:23], s36 offen
    v_mul_f32 v122, v122, v62
    v_mul_f32 v126, v126, v63
    v_cvt_pk_bf16_f32 v42, v114, v118
    v_cvt_pk_bf16_f32 v43, v122, v126
    ds_write_b128 v7, v[32:35] offset:16384
    v_fma_f32 v99, v99, v19, -v23
    v_fma_f32 v103, v103, v19, -v23
    v_fma_f32 v107, v107, v19, -v23
    v_fma_f32 v111, v111, v19, -v23
    v_mul_f32 v99, v99, v56
    buffer_load_dwordx4 v208, s[16:19], s40 offen offset:0 lds
    v_mul_f32 v103, v103, v57
    ds_write_b128 v7, v[36:39] offset:17408
    v_mul_f32 v107, v107, v58
    v_mul_f32 v111, v111, v59
    v_cvt_pk_bf16_f32 v44, v99, v103
    v_cvt_pk_bf16_f32 v45, v107, v111
    v_fma_f32 v115, v115, v19, -v23
    v_fma_f32 v119, v119, v19, -v23
    v_fma_f32 v123, v123, v19, -v23
    buffer_load_dwordx4 v209, s[16:19], s40 offen offset:1024 lds
    ds_write_b128 v7, v[40:43] offset:18432
    v_fma_f32 v127, v127, v19, -v23
    v_mul_f32 v115, v115, v60
    v_mul_f32 v119, v119, v61
    v_mul_f32 v123, v123, v62
    v_mul_f32 v127, v127, v63
    v_cvt_pk_bf16_f32 v46, v115, v119
    v_cvt_pk_bf16_f32 v47, v123, v127
    ds_write_b128 v7, v[44:47] offset:19456
    buffer_load_dwordx4 v210, s[16:19], s40 offen offset:2048 lds
    buffer_load_dwordx4 v211, s[16:19], s40 offen offset:3072 lds
    s_add_u32 m0, s43, 4096
    buffer_load_dwordx4 v212, s[16:19], s40 offen offset:0 lds
    buffer_load_dwordx4 v213, s[16:19], s40 offen offset:1024 lds
    buffer_load_dwordx4 v214, s[16:19], s40 offen offset:2048 lds
    buffer_load_dwordx4 v215, s[16:19], s40 offen offset:3072 lds
    s_add_u32 s43, s43, 32768
    s_cmp_eq_u32 s43, s38
    s_cselect_b32 s43, s39, s43
    s_mov_b32 m0, s43
    s_and_b32 s37, s52, 15
    s_lshr_b64 s[52:53], s[52:53], 4
    s_mul_i32 s36, s37, 917504
    s_lshl_b32 s40, s37, 7
    s_waitcnt vmcnt(16) lgkmcnt(0)
    s_barrier
    buffer_load_dwordx4 v[96:99], v200, s[20:23], s36 offen
    buffer_load_dwordx4 v[100:103], v201, s[20:23], s36 offen
    s_waitcnt vmcnt(10) lgkmcnt(0)
    v_lshl_add_u32 v12, s40, 1, v9
    ds_read_b128 v[56:59], v12
    ds_read_b128 v[60:63], v12 offset:16
    v_fma_f32 v64, v64, v16, -v20
    v_fma_f32 v68, v68, v16, -v20
    v_fma_f32 v72, v72, v16, -v20
    v_fma_f32 v76, v76, v16, -v20
    v_mul_f32 v64, v64, v48
    v_mul_f32 v68, v68, v49
    v_mul_f32 v72, v72, v50
    v_mul_f32 v76, v76, v51
    v_cvt_pk_bf16_f32 v32, v64, v68
    v_cvt_pk_bf16_f32 v33, v72, v76
    buffer_load_dwordx4 v[104:107], v202, s[20:23], s36 offen
    v_fma_f32 v80, v80, v16, -v20
    v_fma_f32 v84, v84, v16, -v20
    v_fma_f32 v88, v88, v16, -v20
    v_fma_f32 v92, v92, v16, -v20
    v_mul_f32 v80, v80, v52
    v_mul_f32 v84, v84, v53
    v_mul_f32 v88, v88, v54
    v_mul_f32 v92, v92, v55
    v_cvt_pk_bf16_f32 v34, v80, v84
    buffer_load_dwordx4 v[108:111], v203, s[20:23], s36 offen
    v_cvt_pk_bf16_f32 v35, v88, v92
    v_fma_f32 v65, v65, v17, -v21
    v_fma_f32 v69, v69, v17, -v21
    v_fma_f32 v73, v73, v17, -v21
    v_fma_f32 v77, v77, v17, -v21
    v_mul_f32 v65, v65, v48
    v_mul_f32 v69, v69, v49
    v_mul_f32 v73, v73, v50
    v_mul_f32 v77, v77, v51
    buffer_load_dwordx4 v[112:115], v204, s[20:23], s36 offen
    v_cvt_pk_bf16_f32 v36, v65, v69
    v_cvt_pk_bf16_f32 v37, v73, v77
    v_fma_f32 v81, v81, v17, -v21
    v_fma_f32 v85, v85, v17, -v21
    v_fma_f32 v89, v89, v17, -v21
    v_fma_f32 v93, v93, v17, -v21
    v_mul_f32 v81, v81, v52
    v_mul_f32 v85, v85, v53
    v_mul_f32 v89, v89, v54
    v_mul_f32 v93, v93, v55
    buffer_load_dwordx4 v[116:119], v205, s[20:23], s36 offen
    v_cvt_pk_bf16_f32 v38, v81, v85
    v_cvt_pk_bf16_f32 v39, v89, v93
    v_fma_f32 v66, v66, v18, -v22
    v_fma_f32 v70, v70, v18, -v22
    v_fma_f32 v74, v74, v18, -v22
    v_fma_f32 v78, v78, v18, -v22
    v_mul_f32 v66, v66, v48
    v_mul_f32 v70, v70, v49
    v_mul_f32 v74, v74, v50
    buffer_load_dwordx4 v[120:123], v206, s[20:23], s36 offen
    v_mul_f32 v78, v78, v51
    v_cvt_pk_bf16_f32 v40, v66, v70
    v_cvt_pk_bf16_f32 v41, v74, v78
    v_fma_f32 v82, v82, v18, -v22
    v_fma_f32 v86, v86, v18, -v22
    v_fma_f32 v90, v90, v18, -v22
    v_fma_f32 v94, v94, v18, -v22
    v_mul_f32 v82, v82, v52
    v_mul_f32 v86, v86, v53
    buffer_load_dwordx4 v[124:127], v207, s[20:23], s36 offen
    v_mul_f32 v90, v90, v54
    v_mul_f32 v94, v94, v55
    v_cvt_pk_bf16_f32 v42, v82, v86
    v_cvt_pk_bf16_f32 v43, v90, v94
    ds_write_b128 v7, v[32:35] offset:0
    v_fma_f32 v67, v67, v19, -v23
    v_fma_f32 v71, v71, v19, -v23
    v_fma_f32 v75, v75, v19, -v23
    v_fma_f32 v79, v79, v19, -v23
    v_mul_f32 v67, v67, v48
    buffer_load_dwordx4 v208, s[16:19], s40 offen offset:0 lds
    v_mul_f32 v71, v71, v49
    ds_write_b128 v7, v[36:39] offset:1024
    v_mul_f32 v75, v75, v50
    v_mul_f32 v79, v79, v51
    v_cvt_pk_bf16_f32 v44, v67, v71
    v_cvt_pk_bf16_f32 v45, v75, v79
    v_fma_f32 v83, v83, v19, -v23
    v_fma_f32 v87, v87, v19, -v23
    v_fma_f32 v91, v91, v19, -v23
    buffer_load_dwordx4 v209, s[16:19], s40 offen offset:1024 lds
    ds_write_b128 v7, v[40:43] offset:2048
    v_fma_f32 v95, v95, v19, -v23
    v_mul_f32 v83, v83, v52
    v_mul_f32 v87, v87, v53
    v_mul_f32 v91, v91, v54
    v_mul_f32 v95, v95, v55
    v_cvt_pk_bf16_f32 v46, v83, v87
    v_cvt_pk_bf16_f32 v47, v91, v95
    ds_write_b128 v7, v[44:47] offset:3072
    buffer_load_dwordx4 v210, s[16:19], s40 offen offset:2048 lds
    buffer_load_dwordx4 v211, s[16:19], s40 offen offset:3072 lds
    s_add_u32 m0, s43, 4096
    buffer_load_dwordx4 v212, s[16:19], s40 offen offset:0 lds
    buffer_load_dwordx4 v213, s[16:19], s40 offen offset:1024 lds
    buffer_load_dwordx4 v214, s[16:19], s40 offen offset:2048 lds
    buffer_load_dwordx4 v215, s[16:19], s40 offen offset:3072 lds
    s_add_u32 s43, s43, 32768
    s_cmp_eq_u32 s43, s38
    s_cselect_b32 s43, s39, s43
    s_mov_b32 m0, s43
    s_and_b32 s37, s52, 15
    s_lshr_b64 s[52:53], s[52:53], 4
    s_mul_i32 s36, s37, 917504
    s_lshl_b32 s40, s37, 7
    s_waitcnt vmcnt(16) lgkmcnt(0)
    s_barrier
    s_sub_u32 s44, s44, 1
    s_cmp_lg_u32 s44, 0
    s_cbranch_scc1 L_p_loop
    buffer_load_dwordx4 v[64:67], v200, s[20:23], s36 offen
    buffer_load_dwordx4 v[68:71], v201, s[20:23], s36 offen
    s_waitcnt vmcnt(10) lgkmcnt(0)
    v_lshl_add_u32 v12, s40, 1, v9
    ds_read_b128 v[48:51], v12
    ds_read_b128 v[52:55], v12 offset:16
    v_fma_f32 v96, v96, v16, -v20
    v_fma_f32 v100, v100, v16, -v20
    v_fma_f32 v104, v104, v16, -v20
    v_fma_f32 v108, v108, v16, -v20
    v_mul_f32 v96, v96, v56
    v_mul_f32 v100, v100, v57
    v_mul_f32 v104, v104, v58
    v_mul_f32 v108, v108, v59
    v_cvt_pk_bf16_f32 v32, v96, v100
    v_cvt_pk_bf16_f32 v33, v104, v108
    buffer_load_dwordx4 v[72:75], v202, s[20:23], s36 offen
    v_fma_f32 v112, v112, v16, -v20
    v_fma_f32 v116, v116, v16, -v20
    v_fma_f32 v120, v120, v16, -v20
    v_fma_f32 v124, v124, v16, -v20
    v_mul_f32 v112, v112, v60
    v_mul_f32 v116, v116, v61
    v_mul_f32 v120, v120, v62
    v_mul_f32 v124, v124, v63
    v_cvt_pk_bf16_f32 v34, v112, v116
    buffer_load_dwordx4 v[76:79], v203, s[20:23], s36 offen
    v_cvt_pk_bf16_f32 v35, v120, v124
    v_fma_f32 v97, v97, v17, -v21
    v_fma_f32 v101, v101, v17, -v21
    v_fma_f32 v105, v105, v17, -v21
    v_fma_f32 v109, v109, v17, -v21
    v_mul_f32 v97, v97, v56
    v_mul_f32 v101, v101, v57
    v_mul_f32 v105, v105, v58
    v_mul_f32 v109, v109, v59
    buffer_load_dwordx4 v[80:83], v204, s[20:23], s36 offen
    v_cvt_pk_bf16_f32 v36, v97, v101
    v_cvt_pk_bf16_f32 v37, v105, v109
    v_fma_f32 v113, v113, v17, -v21
    v_fma_f32 v117, v117, v17, -v21
    v_fma_f32 v121, v121, v17, -v21
    v_fma_f32 v125, v125, v17, -v21
    v_mul_f32 v113, v113, v60
    v_mul_f32 v117, v117, v61
    v_mul_f32 v121, v121, v62
    v_mul_f32 v125, v125, v63
    buffer_load_dwordx4 v[84:87], v205, s[20:23], s36 offen
    v_cvt_pk_bf16_f32 v38, v113, v117
    v_cvt_pk_bf16_f32 v39, v121, v125
    v_fma_f32 v98, v98, v18, -v22
    v_fma_f32 v102, v102, v18, -v22
    v_fma_f32 v106, v106, v18, -v22
    v_fma_f32 v110, v110, v18, -v22
    v_mul_f32 v98, v98, v56
    v_mul_f32 v102, v102, v57
    v_mul_f32 v106, v106, v58
    buffer_load_dwordx4 v[88:91], v206, s[20:23], s36 offen
    v_mul_f32 v110, v110, v59
    v_cvt_pk_bf16_f32 v40, v98, v102
    v_cvt_pk_bf16_f32 v41, v106, v110
    v_fma_f32 v114, v114, v18, -v22
    v_fma_f32 v118, v118, v18, -v22
    v_fma_f32 v122, v122, v18, -v22
    v_fma_f32 v126, v126, v18, -v22
    v_mul_f32 v114, v114, v60
    v_mul_f32 v118, v118, v61
    buffer_load_dwordx4 v[92:95], v207, s[20:23], s36 offen
    v_mul_f32 v122, v122, v62
    v_mul_f32 v126, v126, v63
    v_cvt_pk_bf16_f32 v42, v114, v118
    v_cvt_pk_bf16_f32 v43, v122, v126
    ds_write_b128 v7, v[32:35] offset:16384
    v_fma_f32 v99, v99, v19, -v23
    v_fma_f32 v103, v103, v19, -v23
    v_fma_f32 v107, v107, v19, -v23
    v_fma_f32 v111, v111, v19, -v23
    v_mul_f32 v99, v99, v56
    buffer_load_dwordx4 v208, s[16:19], s40 offen offset:0 lds
    v_mul_f32 v103, v103, v57
    ds_write_b128 v7, v[36:39] offset:17408
    v_mul_f32 v107, v107, v58
    v_mul_f32 v111, v111, v59
    v_cvt_pk_bf16_f32 v44, v99, v103
    v_cvt_pk_bf16_f32 v45, v107, v111
    v_fma_f32 v115, v115, v19, -v23
    v_fma_f32 v119, v119, v19, -v23
    v_fma_f32 v123, v123, v19, -v23
    buffer_load_dwordx4 v209, s[16:19], s40 offen offset:1024 lds
    ds_write_b128 v7, v[40:43] offset:18432
    v_fma_f32 v127, v127, v19, -v23
    v_mul_f32 v115, v115, v60
    v_mul_f32 v119, v119, v61
    v_mul_f32 v123, v123, v62
    v_mul_f32 v127, v127, v63
    v_cvt_pk_bf16_f32 v46, v115, v119
    v_cvt_pk_bf16_f32 v47, v123, v127
    ds_write_b128 v7, v[44:47] offset:19456
    buffer_load_dwordx4 v210, s[16:19], s40 offen offset:2048 lds
    buffer_load_dwordx4 v211, s[16:19], s40 offen offset:3072 lds
    s_add_u32 m0, s43, 4096
    buffer_load_dwordx4 v212, s[16:19], s40 offen offset:0 lds
    buffer_load_dwordx4 v213, s[16:19], s40 offen offset:1024 lds
    buffer_load_dwordx4 v214, s[16:19], s40 offen offset:2048 lds
    buffer_load_dwordx4 v215, s[16:19], s40 offen offset:3072 lds
    s_add_u32 s43, s43, 32768
    s_cmp_eq_u32 s43, s38
    s_cselect_b32 s43, s39, s43
    s_mov_b32 m0, s43
    s_and_b32 s37, s52, 15
    s_lshr_b64 s[52:53], s[52:53], 4
    s_mul_i32 s36, s37, 917504
    s_lshl_b32 s40, s37, 7
    s_waitcnt vmcnt(16) lgkmcnt(0)
    s_barrier
    buffer_load_dwordx4 v[96:99], v200, s[20:23], s36 offen
    buffer_load_dwordx4 v[100:103], v201, s[20:23], s36 offen
    s_waitcnt vmcnt(10) lgkmcnt(0)
    v_lshl_add_u32 v12, s40, 1, v9
    ds_read_b128 v[56:59], v12
    ds_read_b128 v[60:63], v12 offset:16
    v_fma_f32 v64, v64, v16, -v20
    v_fma_f32 v68, v68, v16, -v20
    v_fma_f32 v72, v72, v16, -v20
    v_fma_f32 v76, v76, v16, -v20
    v_mul_f32 v64, v64, v48
    v_mul_f32 v68, v68, v49
    v_mul_f32 v72, v72, v50
    v_mul_f32 v76, v76, v51
    v_cvt_pk_bf16_f32 v32, v64, v68
    v_cvt_pk_bf16_f32 v33, v72, v76
    buffer_load_dwordx4 v[104:107], v202, s[20:23], s36 offen
    v_fma_f32 v80, v80, v16, -v20
    v_fma_f32 v84, v84, v16, -v20
    v_fma_f32 v88, v88, v16, -v20
    v_fma_f32 v92, v92, v16, -v20
    v_mul_f32 v80, v80, v52
    v_mul_f32 v84, v84, v53
    v_mul_f32 v88, v88, v54
    v_mul_f32 v92, v92, v55
    v_cvt_pk_bf16_f32 v34, v80, v84
    buffer_load_dwordx4 v[108:111], v203, s[20:23], s36 offen
    v_cvt_pk_bf16_f32 v35, v88, v92
    v_fma_f32 v65, v65, v17, -v21
    v_fma_f32 v69, v69, v17, -v21
    v_fma_f32 v73, v73, v17, -v21
    v_fma_f32 v77, v77, v17, -v21
    v_mul_f32 v65, v65, v48
    v_mul_f32 v69, v69, v49
    v_mul_f32 v73, v73, v50
    v_mul_f32 v77, v77, v51
    buffer_load_dwordx4 v[112:115], v204, s[20:23], s36 offen
    v_cvt_pk_bf16_f32 v36, v65, v69
    v_cvt_pk_bf16_f32 v37, v73, v77
    v_fma_f32 v81, v81, v17, -v21
    v_fma_f32 v85, v85, v17, -v21
    v_fma_f32 v89, v89, v17, -v21
    v_fma_f32 v93, v93, v17, -v21
    v_mul_f32 v81, v81, v52
    v_mul_f32 v85, v85, v53
    v_mul_f32 v89, v89, v54
    v_mul_f32 v93, v93, v55
    buffer_load_dwordx4 v[116:119], v205, s[20:23], s36 offen
    v_cvt_pk_bf16_f32 v38, v81, v85
    v_cvt_pk_bf16_f32 v39, v89, v93
    v_fma_f32 v66, v66, v18, -v22
    v_fma_f32 v70, v70, v18, -v22
    v_fma_f32 v74, v74, v18, -v22
    v_fma_f32 v78, v78, v18, -v22
    v_mul_f32 v66, v66, v48
    v_mul_f32 v70, v70, v49
    v_mul_f32 v74, v74, v50
    buffer_load_dwordx4 v[120:123], v206, s[20:23], s36 offen
    v_mul_f32 v78, v78, v51
    v_cvt_pk_bf16_f32 v40, v66, v70
    v_cvt_pk_bf16_f32 v41, v74, v78
    v_fma_f32 v82, v82, v18, -v22
    v_fma_f32 v86, v86, v18, -v22
    v_fma_f32 v90, v90, v18, -v22
    v_fma_f32 v94, v94, v18, -v22
    v_mul_f32 v82, v82, v52
    v_mul_f32 v86, v86, v53
    buffer_load_dwordx4 v[124:127], v207, s[20:23], s36 offen
    v_mul_f32 v90, v90, v54
    v_mul_f32 v94, v94, v55
    v_cvt_pk_bf16_f32 v42, v82, v86
    v_cvt_pk_bf16_f32 v43, v90, v94
    ds_write_b128 v7, v[32:35] offset:0
    v_fma_f32 v67, v67, v19, -v23
    v_fma_f32 v71, v71, v19, -v23
    v_fma_f32 v75, v75, v19, -v23
    v_fma_f32 v79, v79, v19, -v23
    v_mul_f32 v67, v67, v48
    buffer_load_dwordx4 v208, s[16:19], s40 offen offset:0 lds
    v_mul_f32 v71, v71, v49
    ds_write_b128 v7, v[36:39] offset:1024
    v_mul_f32 v75, v75, v50
    v_mul_f32 v79, v79, v51
    v_cvt_pk_bf16_f32 v44, v67, v71
    v_cvt_pk_bf16_f32 v45, v75, v79
    v_fma_f32 v83, v83, v19, -v23
    v_fma_f32 v87, v87, v19, -v23
    v_fma_f32 v91, v91, v19, -v23
    buffer_load_dwordx4 v209, s[16:19], s40 offen offset:1024 lds
    ds_write_b128 v7, v[40:43] offset:2048
    v_fma_f32 v95, v95, v19, -v23
    v_mul_f32 v83, v83, v52
    v_mul_f32 v87, v87, v53
    v_mul_f32 v91, v91, v54
    v_mul_f32 v95, v95, v55
    v_cvt_pk_bf16_f32 v46, v83, v87
    v_cvt_pk_bf16_f32 v47, v91, v95
    ds_write_b128 v7, v[44:47] offset:3072
    buffer_load_dwordx4 v210, s[16:19], s40 offen offset:2048 lds
    buffer_load_dwordx4 v211, s[16:19], s40 offen offset:3072 lds
    s_add_u32 m0, s43, 4096
    buffer_load_dwordx4 v212, s[16:19], s40 offen offset:0 lds
    buffer_load_dwordx4 v213, s[16:19], s40 offen offset:1024 lds
    buffer_load_dwordx4 v214, s[16:19], s40 offen offset:2048 lds
    buffer_load_dwordx4 v215, s[16:19], s40 offen offset:3072 lds
    s_waitcnt vmcnt(16) lgkmcnt(0)
    s_barrier
    s_waitcnt vmcnt(8) lgkmcnt(0)
    v_fma_f32 v96, v96, v16, -v20
    v_fma_f32 v100, v100, v16, -v20
    v_fma_f32 v104, v104, v16, -v20
    v_fma_f32 v108, v108, v16, -v20
    v_mul_f32 v96, v96, v56
    v_mul_f32 v100, v100, v57
    v_mul_f32 v104, v104, v58
    v_mul_f32 v108, v108, v59
    v_cvt_pk_bf16_f32 v32, v96, v100
    v_cvt_pk_bf16_f32 v33, v104, v108
    v_fma_f32 v112, v112, v16, -v20
    v_fma_f32 v116, v116, v16, -v20
    v_fma_f32 v120, v120, v16, -v20
    v_fma_f32 v124, v124, v16, -v20
    v_mul_f32 v112, v112, v60
    v_mul_f32 v116, v116, v61
    v_mul_f32 v120, v120, v62
    v_mul_f32 v124, v124, v63
    v_cvt_pk_bf16_f32 v34, v112, v116
    v_cvt_pk_bf16_f32 v35, v120, v124
    ds_write_b128 v7, v[32:35] offset:16384
    v_fma_f32 v97, v97, v17, -v21
    v_fma_f32 v101, v101, v17, -v21
    v_fma_f32 v105, v105, v17, -v21
    v_fma_f32 v109, v109, v17, -v21
    v_mul_f32 v97, v97, v56
    v_mul_f32 v101, v101, v57
    v_mul_f32 v105, v105, v58
    v_mul_f32 v109, v109, v59
    v_cvt_pk_bf16_f32 v36, v97, v101
    v_cvt_pk_bf16_f32 v37, v105, v109
    v_fma_f32 v113, v113, v17, -v21
    v_fma_f32 v117, v117, v17, -v21
    v_fma_f32 v121, v121, v17, -v21
    v_fma_f32 v125, v125, v17, -v21
    v_mul_f32 v113, v113, v60
    v_mul_f32 v117, v117, v61
    v_mul_f32 v121, v121, v62
    v_mul_f32 v125, v125, v63
    v_cvt_pk_bf16_f32 v38, v113, v117
    v_cvt_pk_bf16_f32 v39, v121, v125
    ds_write_b128 v7, v[36:39] offset:17408
    v_fma_f32 v98, v98, v18, -v22
    v_fma_f32 v102, v102, v18, -v22
    v_fma_f32 v106, v106, v18, -v22
    v_fma_f32 v110, v110, v18, -v22
    v_mul_f32 v98, v98, v56
    v_mul_f32 v102, v102, v57
    v_mul_f32 v106, v106, v58
    v_mul_f32 v110, v110, v59
    v_cvt_pk_bf16_f32 v40, v98, v102
    v_cvt_pk_bf16_f32 v41, v106, v110
    v_fma_f32 v114, v114, v18, -v22
    v_fma_f32 v118, v118, v18, -v22
    v_fma_f32 v122, v122, v18, -v22
    v_fma_f32 v126, v126, v18, -v22
    v_mul_f32 v114, v114, v60
    v_mul_f32 v118, v118, v61
    v_mul_f32 v122, v122, v62
    v_mul_f32 v126, v126, v63
    v_cvt_pk_bf16_f32 v42, v114, v118
    v_cvt_pk_bf16_f32 v43, v122, v126
    ds_write_b128 v7, v[40:43] offset:18432
    v_fma_f32 v99, v99, v19, -v23
    v_fma_f32 v103, v103, v19, -v23
    v_fma_f32 v107, v107, v19, -v23
    v_fma_f32 v111, v111, v19, -v23
    v_mul_f32 v99, v99, v56
    v_mul_f32 v103, v103, v57
    v_mul_f32 v107, v107, v58
    v_mul_f32 v111, v111, v59
    v_cvt_pk_bf16_f32 v44, v99, v103
    v_cvt_pk_bf16_f32 v45, v107, v111
    v_fma_f32 v115, v115, v19, -v23
    v_fma_f32 v119, v119, v19, -v23
    v_fma_f32 v123, v123, v19, -v23
    v_fma_f32 v127, v127, v19, -v23
    v_mul_f32 v115, v115, v60
    v_mul_f32 v119, v119, v61
    v_mul_f32 v123, v123, v62
    v_mul_f32 v127, v127, v63
    v_cvt_pk_bf16_f32 v46, v115, v119
    v_cvt_pk_bf16_f32 v47, v123, v127
    ds_write_b128 v7, v[44:47] offset:19456
    s_waitcnt vmcnt(0) lgkmcnt(0)
    s_barrier
    s_endpgm
L_consumer:
    v_lshlrev_b32 v10, 3, v0
    s_waitcnt lgkmcnt(0)
    global_load_dwordx2 v[12:13], v10, s[12:13]
    s_getpc_b64 s[48:49]
L_pc:
    s_sub_u32 s48, s48, L_pc-standalone__weight_only_int_omniquant__prompt_kernel
    s_subb_u32 s49, s49, 0
    s_mov_b32 s50, L_codeend-standalone__weight_only_int_omniquant__prompt_kernel
    s_mov_b32 s51, 0x20000
    s_lshl_b32 s43, s47, 9
    v_lshlrev_b32 v11, 6, v0
    v_add_u32 v14, s43, v11
    v_cmp_gt_u32 vcc, 8, v0
    s_nop 1
    v_cndmask_b32 v11, -1, v14, vcc
    buffer_load_dword v14, v11, s[48:51], 0 offen
    s_and_b32 s42, s2, 1
    s_lshl_b32 s42, s42, 2
    s_add_u32 s29, s29, s42
    s_mul_i32 s34, s29, 1835008
    s_lshl_b32 s35, s31, 8
    s_add_u32 s34, s34, s35
    s_add_u32 s24, s14, s34
    s_addc_u32 s25, s15, 0
    s_sub_u32 s26, 14680064, s34
    s_mov_b32 s27, 0x20000
    v_bfe_u32 v11, v3, 1, 3
    v_xor_b32 v11, v11, v1
    v_lshlrev_b32 v11, 4, v11
    s_lshl_b32 s36, s28, 13
    v_lshl_add_u32 v11, v3, 7, v11
    v_add_u32 v4, s36, v11
    v_xor_b32 v5, 32, v4
    v_xor_b32 v6, 64, v4
    v_xor_b32 v7, 96, v4
    v_mov_b32 v192, v4
    v_mov_b32 v193, v5
    v_mov_b32 v194, v6
    v_mov_b32 v195, v7
    v_lshlrev_b32 v8, 4, v2
    v_add_u32 v8, 98304, v8
    v_lshlrev_b32 v10, 4, v0
    v_add_u32 v10, 131072, v10
    s_mov_b32 s38, 0
    s_waitcnt vmcnt(1)
    v_lshlrev_b32 v16, 16, v12
    v_and_b32 v17, 0xffff0000, v12
    v_lshlrev_b32 v18, 16, v13
    v_and_b32 v19, 0xffff0000, v13
    v_mul_f32 v16, 0x58000000, v16
    v_mul_f32 v17, 0x58000000, v17
    v_mul_f32 v18, 0x58000000, v18
    v_mul_f32 v19, 0x58000000, v19
    ds_write_b128 v10, v[16:19]
    s_lshl_b32 s36, s28, 6
    v_lshl_add_u32 v11, v1, 2, s36
    v_mul_u32_u24 v11, 7168, v11
    v_lshl_add_u32 v9, v3, 3, v11
    s_setprio 1
    s_waitcnt lgkmcnt(0)
    s_barrier
    s_barrier
    ds_read_b128 v[144:147], v192 offset:0
    ds_read_b128 v[160:163], v8 offset:0
    ds_read_b128 v[164:167], v8 offset:1024
    ds_read_b128 v[168:171], v8 offset:2048
    ds_read_b128 v[172:175], v8 offset:3072
    ds_read_b128 v[148:151], v192 offset:4096
    s_waitcnt lgkmcnt(4)
    v_mfma_f32_32x32x16_bf16 v[16:31], v[144:147], v[160:163], 0
    ds_read_b128 v[152:155], v193 offset:0
    s_waitcnt lgkmcnt(4)
    v_mfma_f32_32x32x16_bf16 v[32:47], v[144:147], v[164:167], 0
    ds_read_b128 v[176:179], v8 offset:4096
    s_waitcnt lgkmcnt(4)
    v_mfma_f32_32x32x16_bf16 v[48:63], v[144:147], v[168:171], 0
    ds_read_b128 v[180:183], v8 offset:5120
    s_waitcnt lgkmcnt(4)
    v_mfma_f32_32x32x16_bf16 v[64:79], v[144:147], v[172:175], 0
    ds_read_b128 v[184:187], v8 offset:6144
    s_waitcnt lgkmcnt(4)
    v_mfma_f32_32x32x16_bf16 v[128:143], v[148:151], v[172:175], 0
    ds_read_b128 v[188:191], v8 offset:7168
    v_mfma_f32_32x32x16_bf16 v[112:127], v[148:151], v[168:171], 0
    ds_read_b128 v[156:159], v193 offset:4096
    v_mfma_f32_32x32x16_bf16 v[96:111], v[148:151], v[164:167], 0
    v_mfma_f32_32x32x16_bf16 v[80:95], v[148:151], v[160:163], 0
    s_waitcnt lgkmcnt(4)
    v_mfma_f32_32x32x16_bf16 v[16:31], v[152:155], v[176:179], v[16:31]
    ds_read_b128 v[144:147], v194 offset:0
    s_waitcnt lgkmcnt(4)
    v_mfma_f32_32x32x16_bf16 v[32:47], v[152:155], v[180:183], v[32:47]
    ds_read_b128 v[160:163], v8 offset:8192
    s_waitcnt lgkmcnt(4)
    v_mfma_f32_32x32x16_bf16 v[48:63], v[152:155], v[184:187], v[48:63]
    ds_read_b128 v[164:167], v8 offset:9216
    s_waitcnt lgkmcnt(4)
    v_mfma_f32_32x32x16_bf16 v[64:79], v[152:155], v[188:191], v[64:79]
    ds_read_b128 v[168:171], v8 offset:10240
    s_waitcnt lgkmcnt(4)
    v_mfma_f32_32x32x16_bf16 v[128:143], v[156:159], v[188:191], v[128:143]
    ds_read_b128 v[172:175], v8 offset:11264
    v_mfma_f32_32x32x16_bf16 v[112:127], v[156:159], v[184:187], v[112:127]
    ds_read_b128 v[148:151], v194 offset:4096
    v_mfma_f32_32x32x16_bf16 v[96:111], v[156:159], v[180:183], v[96:111]
    v_mfma_f32_32x32x16_bf16 v[80:95], v[156:159], v[176:179], v[80:95]
    s_waitcnt lgkmcnt(4)
    v_mfma_f32_32x32x16_bf16 v[16:31], v[144:147], v[160:163], v[16:31]
    ds_read_b128 v[152:155], v195 offset:0
    ds_read_b128 v[176:179], v8 offset:12288
    s_waitcnt lgkmcnt(5)
    v_mfma_f32_32x32x16_bf16 v[32:47], v[144:147], v[164:167], v[32:47]
    ds_read_b128 v[180:183], v8 offset:13312
    ds_read_b128 v[184:187], v8 offset:14336
    s_waitcnt lgkmcnt(6)
    v_mfma_f32_32x32x16_bf16 v[48:63], v[144:147], v[168:171], v[48:63]
    ds_read_b128 v[188:191], v8 offset:15360
    ds_read_b128 v[156:159], v195 offset:4096
    s_waitcnt lgkmcnt(7)
    v_mfma_f32_32x32x16_bf16 v[64:79], v[144:147], v[172:175], v[64:79]
    s_add_u32 s38, s38, 32768
    s_cmp_eq_u32 s38, 98304
    s_waitcnt lgkmcnt(6)
    v_mfma_f32_32x32x16_bf16 v[128:143], v[148:151], v[172:175], v[128:143]
    s_cselect_b32 s38, 0, s38
    v_add_u32 v192, s38, v4
    v_mfma_f32_32x32x16_bf16 v[112:127], v[148:151], v[168:171], v[112:127]
    v_add_u32 v193, s38, v5
    v_add_u32 v194, s38, v6
    v_mfma_f32_32x32x16_bf16 v[96:111], v[148:151], v[164:167], v[96:111]
    v_add_u32 v195, s38, v7
    v_mfma_f32_32x32x16_bf16 v[80:95], v[148:151], v[160:163], v[80:95]
    s_waitcnt lgkmcnt(0)
    s_barrier
    s_mov_b32 s44, 6
    .p2align 6
L_c_loop:
    v_mfma_f32_32x32x16_bf16 v[16:31], v[152:155], v[176:179], v[16:31]
    ds_read_b128 v[144:147], v192 offset:0
    v_mfma_f32_32x32x16_bf16 v[32:47], v[152:155], v[180:183], v[32:47]
    ds_read_b128 v[160:163], v8 offset:16384
    v_mfma_f32_32x32x16_bf16 v[48:63], v[152:155], v[184:187], v[48:63]
    ds_read_b128 v[164:167], v8 offset:17408
    v_mfma_f32_32x32x16_bf16 v[64:79], v[152:155], v[188:191], v[64:79]
    ds_read_b128 v[168:171], v8 offset:18432
    v_mfma_f32_32x32x16_bf16 v[128:143], v[156:159], v[188:191], v[128:143]
    ds_read_b128 v[172:175], v8 offset:19456
    v_mfma_f32_32x32x16_bf16 v[112:127], v[156:159], v[184:187], v[112:127]
    ds_read_b128 v[148:151], v192 offset:4096
    v_mfma_f32_32x32x16_bf16 v[96:111], v[156:159], v[180:183], v[96:111]
    v_mfma_f32_32x32x16_bf16 v[80:95], v[156:159], v[176:179], v[80:95]
    s_waitcnt lgkmcnt(4)
    v_mfma_f32_32x32x16_bf16 v[16:31], v[144:147], v[160:163], v[16:31]
    ds_read_b128 v[152:155], v193 offset:0
    s_waitcnt lgkmcnt(4)
    v_mfma_f32_32x32x16_bf16 v[32:47], v[144:147], v[164:167], v[32:47]
    ds_read_b128 v[176:179], v8 offset:20480
    s_waitcnt lgkmcnt(4)
    v_mfma_f32_32x32x16_bf16 v[48:63], v[144:147], v[168:171], v[48:63]
    ds_read_b128 v[180:183], v8 offset:21504
    s_waitcnt lgkmcnt(4)
    v_mfma_f32_32x32x16_bf16 v[64:79], v[144:147], v[172:175], v[64:79]
    ds_read_b128 v[184:187], v8 offset:22528
    s_waitcnt lgkmcnt(4)
    v_mfma_f32_32x32x16_bf16 v[128:143], v[148:151], v[172:175], v[128:143]
    ds_read_b128 v[188:191], v8 offset:23552
    v_mfma_f32_32x32x16_bf16 v[112:127], v[148:151], v[168:171], v[112:127]
    ds_read_b128 v[156:159], v193 offset:4096
    v_mfma_f32_32x32x16_bf16 v[96:111], v[148:151], v[164:167], v[96:111]
    v_mfma_f32_32x32x16_bf16 v[80:95], v[148:151], v[160:163], v[80:95]
    s_waitcnt lgkmcnt(4)
    v_mfma_f32_32x32x16_bf16 v[16:31], v[152:155], v[176:179], v[16:31]
    ds_read_b128 v[144:147], v194 offset:0
    s_waitcnt lgkmcnt(4)
    v_mfma_f32_32x32x16_bf16 v[32:47], v[152:155], v[180:183], v[32:47]
    ds_read_b128 v[160:163], v8 offset:24576
    s_waitcnt lgkmcnt(4)
    v_mfma_f32_32x32x16_bf16 v[48:63], v[152:155], v[184:187], v[48:63]
    ds_read_b128 v[164:167], v8 offset:25600
    s_waitcnt lgkmcnt(4)
    v_mfma_f32_32x32x16_bf16 v[64:79], v[152:155], v[188:191], v[64:79]
    ds_read_b128 v[168:171], v8 offset:26624
    s_waitcnt lgkmcnt(4)
    v_mfma_f32_32x32x16_bf16 v[128:143], v[156:159], v[188:191], v[128:143]
    ds_read_b128 v[172:175], v8 offset:27648
    v_mfma_f32_32x32x16_bf16 v[112:127], v[156:159], v[184:187], v[112:127]
    ds_read_b128 v[148:151], v194 offset:4096
    v_mfma_f32_32x32x16_bf16 v[96:111], v[156:159], v[180:183], v[96:111]
    v_mfma_f32_32x32x16_bf16 v[80:95], v[156:159], v[176:179], v[80:95]
    s_waitcnt lgkmcnt(4)
    v_mfma_f32_32x32x16_bf16 v[16:31], v[144:147], v[160:163], v[16:31]
    ds_read_b128 v[152:155], v195 offset:0
    ds_read_b128 v[176:179], v8 offset:28672
    s_waitcnt lgkmcnt(5)
    v_mfma_f32_32x32x16_bf16 v[32:47], v[144:147], v[164:167], v[32:47]
    ds_read_b128 v[180:183], v8 offset:29696
    ds_read_b128 v[184:187], v8 offset:30720
    s_waitcnt lgkmcnt(6)
    v_mfma_f32_32x32x16_bf16 v[48:63], v[144:147], v[168:171], v[48:63]
    ds_read_b128 v[188:191], v8 offset:31744
    ds_read_b128 v[156:159], v195 offset:4096
    s_waitcnt lgkmcnt(7)
    v_mfma_f32_32x32x16_bf16 v[64:79], v[144:147], v[172:175], v[64:79]
    s_add_u32 s38, s38, 32768
    s_cmp_eq_u32 s38, 98304
    s_waitcnt lgkmcnt(6)
    v_mfma_f32_32x32x16_bf16 v[128:143], v[148:151], v[172:175], v[128:143]
    s_cselect_b32 s38, 0, s38
    v_add_u32 v192, s38, v4
    v_mfma_f32_32x32x16_bf16 v[112:127], v[148:151], v[168:171], v[112:127]
    v_add_u32 v193, s38, v5
    v_add_u32 v194, s38, v6
    v_mfma_f32_32x32x16_bf16 v[96:111], v[148:151], v[164:167], v[96:111]
    v_add_u32 v195, s38, v7
    v_mfma_f32_32x32x16_bf16 v[80:95], v[148:151], v[160:163], v[80:95]
    s_waitcnt lgkmcnt(0)
    s_barrier
    v_mfma_f32_32x32x16_bf16 v[16:31], v[152:155], v[176:179], v[16:31]
    ds_read_b128 v[144:147], v192 offset:0
    v_mfma_f32_32x32x16_bf16 v[32:47], v[152:155], v[180:183], v[32:47]
    ds_read_b128 v[160:163], v8 offset:0
    v_mfma_f32_32x32x16_bf16 v[48:63], v[152:155], v[184:187], v[48:63]
    ds_read_b128 v[164:167], v8 offset:1024
    v_mfma_f32_32x32x16_bf16 v[64:79], v[152:155], v[188:191], v[64:79]
    ds_read_b128 v[168:171], v8 offset:2048
    v_mfma_f32_32x32x16_bf16 v[128:143], v[156:159], v[188:191], v[128:143]
    ds_read_b128 v[172:175], v8 offset:3072
    v_mfma_f32_32x32x16_bf16 v[112:127], v[156:159], v[184:187], v[112:127]
    ds_read_b128 v[148:151], v192 offset:4096
    v_mfma_f32_32x32x16_bf16 v[96:111], v[156:159], v[180:183], v[96:111]
    v_mfma_f32_32x32x16_bf16 v[80:95], v[156:159], v[176:179], v[80:95]
    s_waitcnt lgkmcnt(4)
    v_mfma_f32_32x32x16_bf16 v[16:31], v[144:147], v[160:163], v[16:31]
    ds_read_b128 v[152:155], v193 offset:0
    s_waitcnt lgkmcnt(4)
    v_mfma_f32_32x32x16_bf16 v[32:47], v[144:147], v[164:167], v[32:47]
    ds_read_b128 v[176:179], v8 offset:4096
    s_waitcnt lgkmcnt(4)
    v_mfma_f32_32x32x16_bf16 v[48:63], v[144:147], v[168:171], v[48:63]
    ds_read_b128 v[180:183], v8 offset:5120
    s_waitcnt lgkmcnt(4)
    v_mfma_f32_32x32x16_bf16 v[64:79], v[144:147], v[172:175], v[64:79]
    ds_read_b128 v[184:187], v8 offset:6144
    s_waitcnt lgkmcnt(4)
    v_mfma_f32_32x32x16_bf16 v[128:143], v[148:151], v[172:175], v[128:143]
    ds_read_b128 v[188:191], v8 offset:7168
    v_mfma_f32_32x32x16_bf16 v[112:127], v[148:151], v[168:171], v[112:127]
    ds_read_b128 v[156:159], v193 offset:4096
    v_mfma_f32_32x32x16_bf16 v[96:111], v[148:151], v[164:167], v[96:111]
    v_mfma_f32_32x32x16_bf16 v[80:95], v[148:151], v[160:163], v[80:95]
    s_waitcnt lgkmcnt(4)
    v_mfma_f32_32x32x16_bf16 v[16:31], v[152:155], v[176:179], v[16:31]
    ds_read_b128 v[144:147], v194 offset:0
    s_waitcnt lgkmcnt(4)
    v_mfma_f32_32x32x16_bf16 v[32:47], v[152:155], v[180:183], v[32:47]
    ds_read_b128 v[160:163], v8 offset:8192
    s_waitcnt lgkmcnt(4)
    v_mfma_f32_32x32x16_bf16 v[48:63], v[152:155], v[184:187], v[48:63]
    ds_read_b128 v[164:167], v8 offset:9216
    s_waitcnt lgkmcnt(4)
    v_mfma_f32_32x32x16_bf16 v[64:79], v[152:155], v[188:191], v[64:79]
    ds_read_b128 v[168:171], v8 offset:10240
    s_waitcnt lgkmcnt(4)
    v_mfma_f32_32x32x16_bf16 v[128:143], v[156:159], v[188:191], v[128:143]
    ds_read_b128 v[172:175], v8 offset:11264
    v_mfma_f32_32x32x16_bf16 v[112:127], v[156:159], v[184:187], v[112:127]
    ds_read_b128 v[148:151], v194 offset:4096
    v_mfma_f32_32x32x16_bf16 v[96:111], v[156:159], v[180:183], v[96:111]
    v_mfma_f32_32x32x16_bf16 v[80:95], v[156:159], v[176:179], v[80:95]
    s_waitcnt lgkmcnt(4)
    v_mfma_f32_32x32x16_bf16 v[16:31], v[144:147], v[160:163], v[16:31]
    ds_read_b128 v[152:155], v195 offset:0
    ds_read_b128 v[176:179], v8 offset:12288
    s_waitcnt lgkmcnt(5)
    v_mfma_f32_32x32x16_bf16 v[32:47], v[144:147], v[164:167], v[32:47]
    ds_read_b128 v[180:183], v8 offset:13312
    ds_read_b128 v[184:187], v8 offset:14336
    s_waitcnt lgkmcnt(6)
    v_mfma_f32_32x32x16_bf16 v[48:63], v[144:147], v[168:171], v[48:63]
    ds_read_b128 v[188:191], v8 offset:15360
    ds_read_b128 v[156:159], v195 offset:4096
    s_waitcnt lgkmcnt(7)
    v_mfma_f32_32x32x16_bf16 v[64:79], v[144:147], v[172:175], v[64:79]
    s_add_u32 s38, s38, 32768
    s_cmp_eq_u32 s38, 98304
    s_waitcnt lgkmcnt(6)
    v_mfma_f32_32x32x16_bf16 v[128:143], v[148:151], v[172:175], v[128:143]
    s_cselect_b32 s38, 0, s38
    v_add_u32 v192, s38, v4
    v_mfma_f32_32x32x16_bf16 v[112:127], v[148:151], v[168:171], v[112:127]
    v_add_u32 v193, s38, v5
    v_add_u32 v194, s38, v6
    v_mfma_f32_32x32x16_bf16 v[96:111], v[148:151], v[164:167], v[96:111]
    v_add_u32 v195, s38, v7
    v_mfma_f32_32x32x16_bf16 v[80:95], v[148:151], v[160:163], v[80:95]
    s_waitcnt lgkmcnt(0)
    s_barrier
    s_sub_u32 s44, s44, 1
    s_cmp_lg_u32 s44, 0
    s_cbranch_scc1 L_c_loop
    v_mfma_f32_32x32x16_bf16 v[16:31], v[152:155], v[176:179], v[16:31]
    ds_read_b128 v[144:147], v192 offset:0
    v_mfma_f32_32x32x16_bf16 v[32:47], v[152:155], v[180:183], v[32:47]
    ds_read_b128 v[160:163], v8 offset:16384
    v_mfma_f32_32x32x16_bf16 v[48:63], v[152:155], v[184:187], v[48:63]
    ds_read_b128 v[164:167], v8 offset:17408
    v_mfma_f32_32x32x16_bf16 v[64:79], v[152:155], v[188:191], v[64:79]
    ds_read_b128 v[168:171], v8 offset:18432
    v_mfma_f32_32x32x16_bf16 v[128:143], v[156:159], v[188:191], v[128:143]
    ds_read_b128 v[172:175], v8 offset:19456
    v_mfma_f32_32x32x16_bf16 v[112:127], v[156:159], v[184:187], v[112:127]
    ds_read_b128 v[148:151], v192 offset:4096
    v_mfma_f32_32x32x16_bf16 v[96:111], v[156:159], v[180:183], v[96:111]
    v_mfma_f32_32x32x16_bf16 v[80:95], v[156:159], v[176:179], v[80:95]
    s_waitcnt lgkmcnt(4)
    v_mfma_f32_32x32x16_bf16 v[16:31], v[144:147], v[160:163], v[16:31]
    ds_read_b128 v[152:155], v193 offset:0
    s_waitcnt lgkmcnt(4)
    v_mfma_f32_32x32x16_bf16 v[32:47], v[144:147], v[164:167], v[32:47]
    ds_read_b128 v[176:179], v8 offset:20480
    s_waitcnt lgkmcnt(4)
    v_mfma_f32_32x32x16_bf16 v[48:63], v[144:147], v[168:171], v[48:63]
    ds_read_b128 v[180:183], v8 offset:21504
    s_waitcnt lgkmcnt(4)
    v_mfma_f32_32x32x16_bf16 v[64:79], v[144:147], v[172:175], v[64:79]
    ds_read_b128 v[184:187], v8 offset:22528
    s_waitcnt lgkmcnt(4)
    v_mfma_f32_32x32x16_bf16 v[128:143], v[148:151], v[172:175], v[128:143]
    ds_read_b128 v[188:191], v8 offset:23552
    v_mfma_f32_32x32x16_bf16 v[112:127], v[148:151], v[168:171], v[112:127]
    ds_read_b128 v[156:159], v193 offset:4096
    v_mfma_f32_32x32x16_bf16 v[96:111], v[148:151], v[164:167], v[96:111]
    v_mfma_f32_32x32x16_bf16 v[80:95], v[148:151], v[160:163], v[80:95]
    s_waitcnt lgkmcnt(4)
    v_mfma_f32_32x32x16_bf16 v[16:31], v[152:155], v[176:179], v[16:31]
    ds_read_b128 v[144:147], v194 offset:0
    s_waitcnt lgkmcnt(4)
    v_mfma_f32_32x32x16_bf16 v[32:47], v[152:155], v[180:183], v[32:47]
    ds_read_b128 v[160:163], v8 offset:24576
    s_waitcnt lgkmcnt(4)
    v_mfma_f32_32x32x16_bf16 v[48:63], v[152:155], v[184:187], v[48:63]
    ds_read_b128 v[164:167], v8 offset:25600
    s_waitcnt lgkmcnt(4)
    v_mfma_f32_32x32x16_bf16 v[64:79], v[152:155], v[188:191], v[64:79]
    ds_read_b128 v[168:171], v8 offset:26624
    s_waitcnt lgkmcnt(4)
    v_mfma_f32_32x32x16_bf16 v[128:143], v[156:159], v[188:191], v[128:143]
    ds_read_b128 v[172:175], v8 offset:27648
    v_mfma_f32_32x32x16_bf16 v[112:127], v[156:159], v[184:187], v[112:127]
    ds_read_b128 v[148:151], v194 offset:4096
    v_mfma_f32_32x32x16_bf16 v[96:111], v[156:159], v[180:183], v[96:111]
    v_mfma_f32_32x32x16_bf16 v[80:95], v[156:159], v[176:179], v[80:95]
    s_waitcnt lgkmcnt(4)
    v_mfma_f32_32x32x16_bf16 v[16:31], v[144:147], v[160:163], v[16:31]
    ds_read_b128 v[152:155], v195 offset:0
    ds_read_b128 v[176:179], v8 offset:28672
    s_waitcnt lgkmcnt(5)
    v_mfma_f32_32x32x16_bf16 v[32:47], v[144:147], v[164:167], v[32:47]
    ds_read_b128 v[180:183], v8 offset:29696
    ds_read_b128 v[184:187], v8 offset:30720
    s_waitcnt lgkmcnt(6)
    v_mfma_f32_32x32x16_bf16 v[48:63], v[144:147], v[168:171], v[48:63]
    ds_read_b128 v[188:191], v8 offset:31744
    ds_read_b128 v[156:159], v195 offset:4096
    s_waitcnt lgkmcnt(7)
    v_mfma_f32_32x32x16_bf16 v[64:79], v[144:147], v[172:175], v[64:79]
    s_add_u32 s38, s38, 32768
    s_cmp_eq_u32 s38, 98304
    s_waitcnt lgkmcnt(6)
    v_mfma_f32_32x32x16_bf16 v[128:143], v[148:151], v[172:175], v[128:143]
    s_cselect_b32 s38, 0, s38
    v_add_u32 v192, s38, v4
    v_mfma_f32_32x32x16_bf16 v[112:127], v[148:151], v[168:171], v[112:127]
    v_add_u32 v193, s38, v5
    v_add_u32 v194, s38, v6
    v_mfma_f32_32x32x16_bf16 v[96:111], v[148:151], v[164:167], v[96:111]
    v_add_u32 v195, s38, v7
    v_mfma_f32_32x32x16_bf16 v[80:95], v[148:151], v[160:163], v[80:95]
    s_waitcnt lgkmcnt(0)
    s_barrier
    v_mfma_f32_32x32x16_bf16 v[16:31], v[152:155], v[176:179], v[16:31]
    ds_read_b128 v[144:147], v192 offset:0
    ds_read_b128 v[160:163], v8 offset:0
    v_mfma_f32_32x32x16_bf16 v[32:47], v[152:155], v[180:183], v[32:47]
    ds_read_b128 v[164:167], v8 offset:1024
    ds_read_b128 v[168:171], v8 offset:2048
    v_mfma_f32_32x32x16_bf16 v[48:63], v[152:155], v[184:187], v[48:63]
    ds_read_b128 v[172:175], v8 offset:3072
    ds_read_b128 v[196:199], v193 offset:0
    v_mfma_f32_32x32x16_bf16 v[64:79], v[152:155], v[188:191], v[64:79]
    ds_read_b128 v[200:203], v8 offset:4096
    ds_read_b128 v[204:207], v8 offset:5120
    v_mfma_f32_32x32x16_bf16 v[128:143], v[156:159], v[188:191], v[128:143]
    ds_read_b128 v[208:211], v8 offset:6144
    ds_read_b128 v[212:215], v8 offset:7168
    v_mfma_f32_32x32x16_bf16 v[112:127], v[156:159], v[184:187], v[112:127]
    v_mfma_f32_32x32x16_bf16 v[96:111], v[156:159], v[180:183], v[96:111]
    v_mfma_f32_32x32x16_bf16 v[80:95], v[156:159], v[176:179], v[80:95]
    s_waitcnt lgkmcnt(5)
    v_mfma_f32_32x32x16_bf16 v[16:31], v[144:147], v[160:163], v[16:31]
    ds_read_b128 v[152:155], v194 offset:0
    ds_read_b128 v[176:179], v8 offset:8192
    v_mfma_f32_32x32x16_bf16 v[32:47], v[144:147], v[164:167], v[32:47]
    ds_read_b128 v[180:183], v8 offset:9216
    v_mfma_f32_32x32x16_bf16 v[48:63], v[144:147], v[168:171], v[48:63]
    ds_read_b128 v[184:187], v8 offset:10240
    v_mfma_f32_32x32x16_bf16 v[64:79], v[144:147], v[172:175], v[64:79]
    ds_read_b128 v[188:191], v8 offset:11264
    s_waitcnt lgkmcnt(5)
    v_mfma_f32_32x32x16_bf16 v[16:31], v[196:199], v[200:203], v[16:31]
    ds_read_b128 v[144:147], v195 offset:0
    ds_read_b128 v[160:163], v8 offset:12288
    v_mfma_f32_32x32x16_bf16 v[32:47], v[196:199], v[204:207], v[32:47]
    ds_read_b128 v[164:167], v8 offset:13312
    v_mfma_f32_32x32x16_bf16 v[48:63], v[196:199], v[208:211], v[48:63]
    ds_read_b128 v[168:171], v8 offset:14336
    v_mfma_f32_32x32x16_bf16 v[64:79], v[196:199], v[212:215], v[64:79]
    ds_read_b128 v[172:175], v8 offset:15360
    s_waitcnt lgkmcnt(5)
    s_barrier
    v_mfma_f32_32x32x16_bf16 v[16:31], v[152:155], v[176:179], v[16:31]
    ds_read_b128 v[196:199], v4 offset:0
    ds_read_b128 v[200:203], v8 offset:16384
    v_mfma_f32_32x32x16_bf16 v[32:47], v[152:155], v[180:183], v[32:47]
    ds_read_b128 v[204:207], v8 offset:17408
    v_mfma_f32_32x32x16_bf16 v[48:63], v[152:155], v[184:187], v[48:63]
    ds_read_b128 v[208:211], v8 offset:18432
    v_mfma_f32_32x32x16_bf16 v[64:79], v[152:155], v[188:191], v[64:79]
    ds_read_b128 v[212:215], v8 offset:19456
    s_waitcnt lgkmcnt(5)
    v_mfma_f32_32x32x16_bf16 v[16:31], v[144:147], v[160:163], v[16:31]
    ds_read_b128 v[152:155], v5 offset:0
    ds_read_b128 v[176:179], v8 offset:20480
    v_mfma_f32_32x32x16_bf16 v[32:47], v[144:147], v[164:167], v[32:47]
    ds_read_b128 v[180:183], v8 offset:21504
    v_mfma_f32_32x32x16_bf16 v[48:63], v[144:147], v[168:171], v[48:63]
    ds_read_b128 v[184:187], v8 offset:22528
    v_mfma_f32_32x32x16_bf16 v[64:79], v[144:147], v[172:175], v[64:79]
    ds_read_b128 v[188:191], v8 offset:23552
    s_waitcnt lgkmcnt(5)
    v_mfma_f32_32x32x16_bf16 v[16:31], v[196:199], v[200:203], v[16:31]
    ds_read_b128 v[144:147], v6 offset:0
    ds_read_b128 v[160:163], v8 offset:24576
    v_mfma_f32_32x32x16_bf16 v[32:47], v[196:199], v[204:207], v[32:47]
    ds_read_b128 v[164:167], v8 offset:25600
    v_mfma_f32_32x32x16_bf16 v[48:63], v[196:199], v[208:211], v[48:63]
    ds_read_b128 v[168:171], v8 offset:26624
    v_mfma_f32_32x32x16_bf16 v[64:79], v[196:199], v[212:215], v[64:79]
    ds_read_b128 v[172:175], v8 offset:27648
    s_waitcnt lgkmcnt(5)
    v_mfma_f32_32x32x16_bf16 v[16:31], v[152:155], v[176:179], v[16:31]
    ds_read_b128 v[196:199], v7 offset:0
    ds_read_b128 v[200:203], v8 offset:28672
    v_mfma_f32_32x32x16_bf16 v[32:47], v[152:155], v[180:183], v[32:47]
    ds_read_b128 v[204:207], v8 offset:29696
    v_mfma_f32_32x32x16_bf16 v[48:63], v[152:155], v[184:187], v[48:63]
    ds_read_b128 v[208:211], v8 offset:30720
    v_mfma_f32_32x32x16_bf16 v[64:79], v[152:155], v[188:191], v[64:79]
    ds_read_b128 v[212:215], v8 offset:31744
    s_waitcnt lgkmcnt(5)
    v_mfma_f32_32x32x16_bf16 v[16:31], v[144:147], v[160:163], v[16:31]
    ds_read_b128 v[152:155], v192 offset:4096
    ds_read_b128 v[176:179], v8 offset:0
    v_mfma_f32_32x32x16_bf16 v[32:47], v[144:147], v[164:167], v[32:47]
    ds_read_b128 v[180:183], v8 offset:1024
    v_mfma_f32_32x32x16_bf16 v[48:63], v[144:147], v[168:171], v[48:63]
    ds_read_b128 v[184:187], v8 offset:2048
    v_mfma_f32_32x32x16_bf16 v[64:79], v[144:147], v[172:175], v[64:79]
    ds_read_b128 v[188:191], v8 offset:3072
    s_waitcnt lgkmcnt(5)
    v_mfma_f32_32x32x16_bf16 v[16:31], v[196:199], v[200:203], v[16:31]
    ds_read_b128 v[144:147], v193 offset:4096
    ds_read_b128 v[160:163], v8 offset:4096
    v_mfma_f32_32x32x16_bf16 v[32:47], v[196:199], v[204:207], v[32:47]
    ds_read_b128 v[164:167], v8 offset:5120
    v_mfma_f32_32x32x16_bf16 v[48:63], v[196:199], v[208:211], v[48:63]
    ds_read_b128 v[168:171], v8 offset:6144
    v_mfma_f32_32x32x16_bf16 v[64:79], v[196:199], v[212:215], v[64:79]
    ds_read_b128 v[172:175], v8 offset:7168
    s_waitcnt lgkmcnt(5)
    v_mfma_f32_32x32x16_bf16 v[80:95], v[152:155], v[176:179], v[80:95]
    ds_read_b128 v[196:199], v194 offset:4096
    ds_read_b128 v[200:203], v8 offset:8192
    v_mfma_f32_32x32x16_bf16 v[96:111], v[152:155], v[180:183], v[96:111]
    ds_read_b128 v[204:207], v8 offset:9216
    v_mfma_f32_32x32x16_bf16 v[112:127], v[152:155], v[184:187], v[112:127]
    ds_read_b128 v[208:211], v8 offset:10240
    v_mfma_f32_32x32x16_bf16 v[128:143], v[152:155], v[188:191], v[128:143]
    ds_read_b128 v[212:215], v8 offset:11264
    s_waitcnt lgkmcnt(5)
    v_mfma_f32_32x32x16_bf16 v[80:95], v[144:147], v[160:163], v[80:95]
    ds_read_b128 v[152:155], v195 offset:4096
    ds_read_b128 v[176:179], v8 offset:12288
    v_cvt_pk_bf16_f32 v216, v16, v32
    v_cvt_pk_bf16_f32 v217, v48, v64
    s_mov_b32 s36, 0
    v_mfma_f32_32x32x16_bf16 v[96:111], v[144:147], v[164:167], v[96:111]
    ds_read_b128 v[180:183], v8 offset:13312
    buffer_store_dwordx2 v[216:217], v9, s[24:27], s36 offen sc1 nt
    v_cvt_pk_bf16_f32 v218, v17, v33
    v_cvt_pk_bf16_f32 v219, v49, v65
    v_mfma_f32_32x32x16_bf16 v[112:127], v[144:147], v[168:171], v[112:127]
    ds_read_b128 v[184:187], v8 offset:14336
    s_mov_b32 s36, 7168
    buffer_store_dwordx2 v[218:219], v9, s[24:27], s36 offen sc1 nt
    v_cvt_pk_bf16_f32 v220, v18, v34
    v_mfma_f32_32x32x16_bf16 v[128:143], v[144:147], v[172:175], v[128:143]
    ds_read_b128 v[188:191], v8 offset:15360
    v_cvt_pk_bf16_f32 v221, v50, v66
    s_mov_b32 s36, 14336
    buffer_store_dwordx2 v[220:221], v9, s[24:27], s36 offen sc1 nt
    s_waitcnt lgkmcnt(5)
    v_mfma_f32_32x32x16_bf16 v[80:95], v[196:199], v[200:203], v[80:95]
    ds_read_b128 v[144:147], v4 offset:4096
    ds_read_b128 v[160:163], v8 offset:16384
    v_cvt_pk_bf16_f32 v222, v19, v35
    v_cvt_pk_bf16_f32 v223, v51, v67
    s_mov_b32 s36, 21504
    v_mfma_f32_32x32x16_bf16 v[96:111], v[196:199], v[204:207], v[96:111]
    ds_read_b128 v[164:167], v8 offset:17408
    buffer_store_dwordx2 v[222:223], v9, s[24:27], s36 offen sc1 nt
    v_cvt_pk_bf16_f32 v224, v20, v36
    v_cvt_pk_bf16_f32 v225, v52, v68
    v_mfma_f32_32x32x16_bf16 v[112:127], v[196:199], v[208:211], v[112:127]
    ds_read_b128 v[168:171], v8 offset:18432
    s_mov_b32 s36, 57344
    buffer_store_dwordx2 v[224:225], v9, s[24:27], s36 offen sc1 nt
    v_cvt_pk_bf16_f32 v226, v21, v37
    v_mfma_f32_32x32x16_bf16 v[128:143], v[196:199], v[212:215], v[128:143]
    ds_read_b128 v[172:175], v8 offset:19456
    v_cvt_pk_bf16_f32 v227, v53, v69
    s_mov_b32 s36, 64512
    buffer_store_dwordx2 v[226:227], v9, s[24:27], s36 offen sc1 nt
    s_waitcnt lgkmcnt(5)
    v_mfma_f32_32x32x16_bf16 v[80:95], v[152:155], v[176:179], v[80:95]
    ds_read_b128 v[196:199], v5 offset:4096
    ds_read_b128 v[200:203], v8 offset:20480
    v_cvt_pk_bf16_f32 v228, v22, v38
    v_cvt_pk_bf16_f32 v229, v54, v70
    v_mfma_f32_32x32x16_bf16 v[96:111], v[152:155], v[180:183], v[96:111]
    ds_read_b128 v[204:207], v8 offset:21504
    s_mov_b32 s36, 71680
    buffer_store_dwordx2 v[228:229], v9, s[24:27], s36 offen sc1 nt
    v_mfma_f32_32x32x16_bf16 v[112:127], v[152:155], v[184:187], v[112:127]
    ds_read_b128 v[208:211], v8 offset:22528
    v_cvt_pk_bf16_f32 v230, v23, v39
    v_cvt_pk_bf16_f32 v231, v55, v71
    v_mfma_f32_32x32x16_bf16 v[128:143], v[152:155], v[188:191], v[128:143]
    ds_read_b128 v[212:215], v8 offset:23552
    s_mov_b32 s36, 78848
    buffer_store_dwordx2 v[230:231], v9, s[24:27], s36 offen sc1 nt
    s_waitcnt lgkmcnt(5)
    v_mfma_f32_32x32x16_bf16 v[80:95], v[144:147], v[160:163], v[80:95]
    ds_read_b128 v[152:155], v6 offset:4096
    ds_read_b128 v[176:179], v8 offset:24576
    v_cvt_pk_bf16_f32 v232, v24, v40
    v_cvt_pk_bf16_f32 v233, v56, v72
    v_mfma_f32_32x32x16_bf16 v[96:111], v[144:147], v[164:167], v[96:111]
    ds_read_b128 v[180:183], v8 offset:25600
    s_mov_b32 s36, 114688
    buffer_store_dwordx2 v[232:233], v9, s[24:27], s36 offen sc1 nt
    v_mfma_f32_32x32x16_bf16 v[112:127], v[144:147], v[168:171], v[112:127]
    ds_read_b128 v[184:187], v8 offset:26624
    v_cvt_pk_bf16_f32 v234, v25, v41
    v_cvt_pk_bf16_f32 v235, v57, v73
    v_mfma_f32_32x32x16_bf16 v[128:143], v[144:147], v[172:175], v[128:143]
    ds_read_b128 v[188:191], v8 offset:27648
    s_mov_b32 s36, 121856
    buffer_store_dwordx2 v[234:235], v9, s[24:27], s36 offen sc1 nt
    s_waitcnt lgkmcnt(5)
    v_mfma_f32_32x32x16_bf16 v[80:95], v[196:199], v[200:203], v[80:95]
    ds_read_b128 v[144:147], v7 offset:4096
    ds_read_b128 v[160:163], v8 offset:28672
    v_cvt_pk_bf16_f32 v236, v26, v42
    v_cvt_pk_bf16_f32 v237, v58, v74
    v_mfma_f32_32x32x16_bf16 v[96:111], v[196:199], v[204:207], v[96:111]
    ds_read_b128 v[164:167], v8 offset:29696
    s_mov_b32 s36, 129024
    buffer_store_dwordx2 v[236:237], v9, s[24:27], s36 offen sc1 nt
    v_mfma_f32_32x32x16_bf16 v[112:127], v[196:199], v[208:211], v[112:127]
    ds_read_b128 v[168:171], v8 offset:30720
    v_cvt_pk_bf16_f32 v238, v27, v43
    v_cvt_pk_bf16_f32 v239, v59, v75
    v_mfma_f32_32x32x16_bf16 v[128:143], v[196:199], v[212:215], v[128:143]
    ds_read_b128 v[172:175], v8 offset:31744
    s_mov_b32 s36, 136192
    buffer_store_dwordx2 v[238:239], v9, s[24:27], s36 offen sc1 nt
    s_waitcnt lgkmcnt(5)
    v_mfma_f32_32x32x16_bf16 v[80:95], v[152:155], v[176:179], v[80:95]
    v_cvt_pk_bf16_f32 v240, v28, v44
    v_cvt_pk_bf16_f32 v241, v60, v76
    v_mfma_f32_32x32x16_bf16 v[96:111], v[152:155], v[180:183], v[96:111]
    s_mov_b32 s36, 172032
    buffer_store_dwordx2 v[240:241], v9, s[24:27], s36 offen sc1 nt
    v_mfma_f32_32x32x16_bf16 v[112:127], v[152:155], v[184:187], v[112:127]
    v_cvt_pk_bf16_f32 v242, v29, v45
    v_cvt_pk_bf16_f32 v243, v61, v77
    v_mfma_f32_32x32x16_bf16 v[128:143], v[152:155], v[188:191], v[128:143]
    s_mov_b32 s36, 179200
    buffer_store_dwordx2 v[242:243], v9, s[24:27], s36 offen sc1 nt
    s_waitcnt lgkmcnt(0)
    v_mfma_f32_32x32x16_bf16 v[80:95], v[144:147], v[160:163], v[80:95]
    v_cvt_pk_bf16_f32 v244, v30, v46
    v_cvt_pk_bf16_f32 v245, v62, v78
    v_mfma_f32_32x32x16_bf16 v[96:111], v[144:147], v[164:167], v[96:111]
    s_mov_b32 s36, 186368
    buffer_store_dwordx2 v[244:245], v9, s[24:27], s36 offen sc1 nt
    v_mfma_f32_32x32x16_bf16 v[112:127], v[144:147], v[168:171], v[112:127]
    v_cvt_pk_bf16_f32 v246, v31, v47
    v_cvt_pk_bf16_f32 v247, v63, v79
    v_mfma_f32_32x32x16_bf16 v[128:143], v[144:147], v[172:175], v[128:143]
    s_mov_b32 s36, 193536
    buffer_store_dwordx2 v[246:247], v9, s[24:27], s36 offen sc1 nt
    s_nop 7
    s_nop 7
    v_cvt_pk_bf16_f32 v216, v80, v96
    v_cvt_pk_bf16_f32 v217, v112, v128
    s_mov_b32 s36, 229376
    buffer_store_dwordx2 v[216:217], v9, s[24:27], s36 offen sc1 nt
    v_cvt_pk_bf16_f32 v218, v81, v97
    v_cvt_pk_bf16_f32 v219, v113, v129
    s_mov_b32 s36, 236544
    buffer_store_dwordx2 v[218:219], v9, s[24:27], s36 offen sc1 nt
    v_cvt_pk_bf16_f32 v220, v82, v98
    v_cvt_pk_bf16_f32 v221, v114, v130
    s_mov_b32 s36, 243712
    buffer_store_dwordx2 v[220:221], v9, s[24:27], s36 offen sc1 nt
    v_cvt_pk_bf16_f32 v222, v83, v99
    v_cvt_pk_bf16_f32 v223, v115, v131
    s_mov_b32 s36, 250880
    buffer_store_dwordx2 v[222:223], v9, s[24:27], s36 offen sc1 nt
    v_cvt_pk_bf16_f32 v224, v84, v100
    v_cvt_pk_bf16_f32 v225, v116, v132
    s_mov_b32 s36, 286720
    buffer_store_dwordx2 v[224:225], v9, s[24:27], s36 offen sc1 nt
    v_cvt_pk_bf16_f32 v226, v85, v101
    v_cvt_pk_bf16_f32 v227, v117, v133
    s_mov_b32 s36, 293888
    buffer_store_dwordx2 v[226:227], v9, s[24:27], s36 offen sc1 nt
    v_cvt_pk_bf16_f32 v228, v86, v102
    v_cvt_pk_bf16_f32 v229, v118, v134
    s_mov_b32 s36, 301056
    buffer_store_dwordx2 v[228:229], v9, s[24:27], s36 offen sc1 nt
    v_cvt_pk_bf16_f32 v230, v87, v103
    v_cvt_pk_bf16_f32 v231, v119, v135
    s_mov_b32 s36, 308224
    buffer_store_dwordx2 v[230:231], v9, s[24:27], s36 offen sc1 nt
    v_cvt_pk_bf16_f32 v232, v88, v104
    v_cvt_pk_bf16_f32 v233, v120, v136
    s_mov_b32 s36, 344064
    buffer_store_dwordx2 v[232:233], v9, s[24:27], s36 offen sc1 nt
    v_cvt_pk_bf16_f32 v234, v89, v105
    v_cvt_pk_bf16_f32 v235, v121, v137
    s_mov_b32 s36, 351232
    buffer_store_dwordx2 v[234:235], v9, s[24:27], s36 offen sc1 nt
    v_cvt_pk_bf16_f32 v236, v90, v106
    v_cvt_pk_bf16_f32 v237, v122, v138
    s_mov_b32 s36, 358400
    buffer_store_dwordx2 v[236:237], v9, s[24:27], s36 offen sc1 nt
    v_cvt_pk_bf16_f32 v238, v91, v107
    v_cvt_pk_bf16_f32 v239, v123, v139
    s_mov_b32 s36, 365568
    buffer_store_dwordx2 v[238:239], v9, s[24:27], s36 offen sc1 nt
    v_cvt_pk_bf16_f32 v240, v92, v108
    v_cvt_pk_bf16_f32 v241, v124, v140
    s_mov_b32 s36, 401408
    buffer_store_dwordx2 v[240:241], v9, s[24:27], s36 offen sc1 nt
    v_cvt_pk_bf16_f32 v242, v93, v109
    v_cvt_pk_bf16_f32 v243, v125, v141
    s_mov_b32 s36, 408576
    buffer_store_dwordx2 v[242:243], v9, s[24:27], s36 offen sc1 nt
    v_cvt_pk_bf16_f32 v244, v94, v110
    v_cvt_pk_bf16_f32 v245, v126, v142
    s_mov_b32 s36, 415744
    buffer_store_dwordx2 v[244:245], v9, s[24:27], s36 offen sc1 nt
    v_cvt_pk_bf16_f32 v246, v95, v111
    v_cvt_pk_bf16_f32 v247, v127, v143
    s_mov_b32 s36, 422912
    buffer_store_dwordx2 v[246:247], v9, s[24:27], s36 offen sc1 nt
    s_endpgm
L_exit:
    s_endpgm
L_codeend:
.section .rodata,"a"
.p2align 6
.amdhsa_kernel standalone__weight_only_int_omniquant__prompt_kernel
  .amdhsa_next_free_vgpr 256
  .amdhsa_next_free_sgpr 96
  .amdhsa_accum_offset 256
  .amdhsa_group_segment_fixed_size 0
  .amdhsa_kernarg_size 64
  .amdhsa_user_sgpr_count 2
  .amdhsa_user_sgpr_kernarg_segment_ptr 1
  .amdhsa_system_sgpr_workgroup_id_x 1
  .amdhsa_float_denorm_mode_32 3
.end_amdhsa_kernel
```
